```python
import torch

def _softmax(x, axis=-1):
    return torch.softmax(x, dim=axis)
def _gelu(x):
    return torch.nn.functional.gelu(x, approximate="tanh")
def _silu(x):
    return torch.nn.functional.silu(x)
def _sigmoid(x):
    return torch.sigmoid(x)
def _layernorm(x, axis=-1, eps=1e-5):
    m = x.mean(dim=axis, keepdim=True)
    v = x.var(dim=axis, keepdim=True, unbiased=False)
    return (x - m) / torch.sqrt(v + eps)
def _scatter_add(tgt, idx, src, axis=0):
    return tgt.clone().index_add_(axis, idx, src)
def _segment_sum(src, seg, n):
    out = torch.zeros((n,) + src.shape[1:], dtype=src.dtype)
    return out.index_add_(0, seg, src)
def _pad(x, pw):
    flat = tuple(v for pair in reversed(pw) for v in pair)
    return torch.nn.functional.pad(x, flat)

kernel_name = 'standalone__groupnorm__prompt'

def setup_inputs():

    _w = (lambda a: (lambda t: t.to(torch.bfloat16) if t.is_floating_point() else t)(torch.as_tensor(a)))
    B = 2
    G = 32
    cpg = max(1, 1024 // G)
    C = G * cpg
    H, W = 32, 2048
    return {
        "x": _w(abs((lambda *s: torch.randn(*s, dtype=torch.bfloat16) * 0.05)(B, C, H, W))),
        "g": _w((lambda *s: torch.randn(*s, dtype=torch.bfloat16) * 0.05)(C) + 1.0),
        "b": _w((lambda *s: torch.randn(*s, dtype=torch.bfloat16) * 0.4)(C)),
    }

def reference(x, g, b):
    G = 32
    B, C, H, W = x.shape[0], x.shape[1], x.shape[2], x.shape[3]
    xr = x.reshape(B, G, C // G, H, W)
    mu = xr.mean(axis=(2, 3, 4), keepdims=True)
    var = ((xr - mu) ** 2).mean(axis=(2, 3, 4), keepdims=True)
    xn = (xr - mu) / torch.sqrt(var + 1e-5)
    xn = xn.reshape(B, C, H, W)
    return xn * g[None, :, None, None] + b[None, :, None, None]
```

```asm
; @launch grid=(256,1,1) block=(1024,1,1) lds=64
.amdgcn_target "amdgcn-amd-amdhsa--gfx950"
.text
.globl standalone__groupnorm__prompt_kernel
.p2align 8
.type standalone__groupnorm__prompt_kernel,@function
standalone__groupnorm__prompt_kernel:
    s_load_dwordx4 s[4:7], s[0:1], 0
    s_load_dwordx4 s[8:11], s[0:1], 16
    s_load_dwordx2 s[14:15], s[0:1], 40
    s_cmp_ge_u32 s2, 256
    s_cbranch_scc1 L_end
    v_add_u32 v2, 960, v0
    v_bfe_u32 v2, v2, 6, 4
    v_and_b32 v3, 63, v0
    s_mov_b32 s18, 0x10000000
    v_readfirstlane_b32 s36, v2
    s_getpc_b64 s[48:49]
L_pc:
    v_lshlrev_b32 v4, 7, v3
    v_min_u32 v4, L_last-L_pc, v4
    s_cmp_lg_u32 s36, 14
    s_cbranch_scc1 L_nopf
    global_load_dword v5, v4, s[48:49]
L_nopf:
    s_mov_b32 s19, 0x00020000
    s_mov_b32 s22, s18
    s_mov_b32 s23, 0x00020000
    s_mov_b32 s26, 458752
    s_mov_b32 s27, 0x00020000
    s_mov_b32 s37, 0x3f803f80
    s_mov_b32 s38, 0xffff0000
    s_mov_b32 s39, 0
    s_mov_b32 s43, 0
    s_mov_b32 s56, 0
    s_mov_b32 s33, s36
    s_mov_b32 s34, s2
    v_lshlrev_b32 v20, 4, v3
    s_lshr_b32 s42, s34, 3
    s_lshl_b32 s44, s42, 2
    s_and_b32 s45, s34, 3
    s_or_b32 s44, s44, s45
    s_lshl_b32 s44, s44, 15
    s_lshl_b32 s45, s33, 22
    s_or_b32 s28, s44, s45
    s_and_b32 s44, s34, 4
    s_lshl_b32 s44, s44, 11
    s_or_b32 s28, s28, s44
    s_or_b32 s29, s28, 0x1000
    s_xor_b32 s30, s28, 0x6000
    s_xor_b32 s31, s29, 0x6000
    v_and_b32 v6, 1, v3
    v_lshlrev_b32 v6, 4, v6
    v_mov_b32 v7, 0xffff
    v_lshlrev_b32 v6, v6, v7
    v_bfe_i32 v7, v3, 1, 1
    v_and_b32 v23, v7, v6
    v_xor_b32 v22, v23, v6
    s_and_b32 s46, s2, 63
    s_lshr_b32 s45, s2, 6
    s_lshl_b32 s46, s46, 7
    s_lshl_b32 s45, s45, 14
    s_or_b32 s45, s45, s46
    s_and_b32 s46, s2, 8
    s_lshl_b32 s46, s46, 10
    s_or_b32 s45, s45, s46
    s_cmp_le_u32 s36, 0
    s_waitcnt lgkmcnt(0)
    s_load_dword s41, s[14:15], 264192
    s_mov_b64 s[16:17], s[4:5]
    s_mov_b64 s[20:21], s[10:11]
    s_mov_b64 s[24:25], s[14:15]
    s_cbranch_scc1 L_t0
    s_add_u32 s12, s4, 0x8000
    s_addc_u32 s13, s5, 0
    s_and_b32 s12, s12, 0xffffc000
    s_lshr_b32 s46, s12, 8
    s_and_b32 s46, s46, 0x2000
    s_xor_b32 s45, s45, s46
    s_add_u32 s12, s12, s45
    s_addc_u32 s13, s13, 0
    s_cmp_lg_u32 s36, 15
    s_cbranch_scc1 L_s1
    s_load_dword s47, s[12:13], 0
    s_lshl_b32 s44, s2, 9
    s_add_u32 s44, s44, 65536
    v_mov_b32 v8, -1
    v_mov_b32 v9, -1
    v_mov_b32 v10, -1
    v_mov_b32 v11, -1
    s_mov_b32 exec_hi, 0
    buffer_store_dwordx4 v[8:11], v20, s[24:27], s44 offen sc1
    s_mov_b32 exec_hi, -1
    s_cmp_ge_u32 s2, 32
    s_cbranch_scc1 L_s1
    s_mul_i32 s44, s2, 4352
    s_add_u32 s44, s44, 266240
    s_mov_b32 s45, 0
    s_atomic_swap s45, s[14:15], s44 glc
L_s1:
    s_barrier
    s_cmp_eq_u32 s36, 1
    s_cbranch_scc1 L_t0
    s_cmp_eq_u32 s36, 15
    s_cbranch_scc1 L_w15
    s_barrier
    s_cmp_eq_u32 s36, 2
    s_cbranch_scc1 L_t0
    s_cmp_ge_u32 s36, 8
    s_cselect_b32 s44, 3, 2
    s_sub_u32 s44, s36, s44
    s_waitcnt vmcnt(0) lgkmcnt(0)
L_stag:
    s_barrier
    s_sub_u32 s44, s44, 1
    s_cmp_lg_u32 s44, 0
    s_cbranch_scc1 L_stag
    s_cmp_ge_u32 s36, 8
    s_cbranch_scc1 L_role0
L_t0:
    buffer_load_dwordx4 v[24:27], v20, s[16:19], s28 offen offset:0 nt
    buffer_load_dwordx4 v[28:31], v20, s[16:19], s28 offen offset:1024 nt
    buffer_load_dwordx4 v[32:35], v20, s[16:19], s28 offen offset:2048 nt
    buffer_load_dwordx4 v[36:39], v20, s[16:19], s28 offen offset:3072 nt
    buffer_load_dwordx4 v[40:43], v20, s[16:19], s29 offen offset:0 nt
    buffer_load_dwordx4 v[44:47], v20, s[16:19], s29 offen offset:1024 nt
    buffer_load_dwordx4 v[48:51], v20, s[16:19], s29 offen offset:2048 nt
    buffer_load_dwordx4 v[52:55], v20, s[16:19], s29 offen offset:3072 nt
    buffer_load_dwordx4 v[56:59], v20, s[16:19], s30 offen offset:0 nt
    buffer_load_dwordx4 v[60:63], v20, s[16:19], s30 offen offset:1024 nt
    buffer_load_dwordx4 v[64:67], v20, s[16:19], s30 offen offset:2048 nt
    buffer_load_dwordx4 v[68:71], v20, s[16:19], s30 offen offset:3072 nt
    buffer_load_dwordx4 v[72:75], v20, s[16:19], s31 offen offset:0 nt
    buffer_load_dwordx4 v[76:79], v20, s[16:19], s31 offen offset:1024 nt
    buffer_load_dwordx4 v[80:83], v20, s[16:19], s31 offen offset:2048 nt
    buffer_load_dwordx4 v[84:87], v20, s[16:19], s31 offen offset:3072 nt
    s_barrier
    s_barrier
    v_mov_b32 v4, 0
    v_mov_b32 v5, 0
    v_mov_b32 v6, 0
    v_mov_b32 v7, 0
    v_mov_b32 v8, 0
    v_mov_b32 v9, 0
    v_mov_b32 v10, 0
    v_mov_b32 v11, 0
    s_waitcnt vmcnt(15)
    v_dot2c_f32_bf16 v4, s37, v24
    v_dot2c_f32_bf16 v5, s37, v25
    v_dot2c_f32_bf16 v6, s37, v26
    v_dot2c_f32_bf16 v7, s37, v27
    v_dot2c_f32_bf16 v8, v24, v24
    v_dot2c_f32_bf16 v9, v25, v25
    v_dot2c_f32_bf16 v10, v26, v26
    v_dot2c_f32_bf16 v11, v27, v27
    s_waitcnt vmcnt(14)
    v_dot2c_f32_bf16 v4, s37, v28
    v_dot2c_f32_bf16 v5, s37, v29
    v_dot2c_f32_bf16 v6, s37, v30
    v_dot2c_f32_bf16 v7, s37, v31
    v_dot2c_f32_bf16 v8, v28, v28
    v_dot2c_f32_bf16 v9, v29, v29
    v_dot2c_f32_bf16 v10, v30, v30
    v_dot2c_f32_bf16 v11, v31, v31
    s_waitcnt vmcnt(13)
    v_dot2c_f32_bf16 v4, s37, v32
    v_dot2c_f32_bf16 v5, s37, v33
    v_dot2c_f32_bf16 v6, s37, v34
    v_dot2c_f32_bf16 v7, s37, v35
    v_dot2c_f32_bf16 v8, v32, v32
    v_dot2c_f32_bf16 v9, v33, v33
    v_dot2c_f32_bf16 v10, v34, v34
    v_dot2c_f32_bf16 v11, v35, v35
    s_waitcnt vmcnt(12)
    v_dot2c_f32_bf16 v4, s37, v36
    v_dot2c_f32_bf16 v5, s37, v37
    v_dot2c_f32_bf16 v6, s37, v38
    v_dot2c_f32_bf16 v7, s37, v39
    v_dot2c_f32_bf16 v8, v36, v36
    v_dot2c_f32_bf16 v9, v37, v37
    v_dot2c_f32_bf16 v10, v38, v38
    v_dot2c_f32_bf16 v11, v39, v39
    s_waitcnt vmcnt(11)
    v_dot2c_f32_bf16 v4, s37, v40
    v_dot2c_f32_bf16 v5, s37, v41
    v_dot2c_f32_bf16 v6, s37, v42
    v_dot2c_f32_bf16 v7, s37, v43
    v_dot2c_f32_bf16 v8, v40, v40
    v_dot2c_f32_bf16 v9, v41, v41
    v_dot2c_f32_bf16 v10, v42, v42
    v_dot2c_f32_bf16 v11, v43, v43
    s_waitcnt vmcnt(10)
    v_dot2c_f32_bf16 v4, s37, v44
    v_dot2c_f32_bf16 v5, s37, v45
    v_dot2c_f32_bf16 v6, s37, v46
    v_dot2c_f32_bf16 v7, s37, v47
    v_dot2c_f32_bf16 v8, v44, v44
    v_dot2c_f32_bf16 v9, v45, v45
    v_dot2c_f32_bf16 v10, v46, v46
    v_dot2c_f32_bf16 v11, v47, v47
    s_waitcnt vmcnt(9)
    v_dot2c_f32_bf16 v4, s37, v48
    v_dot2c_f32_bf16 v5, s37, v49
    v_dot2c_f32_bf16 v6, s37, v50
    v_dot2c_f32_bf16 v7, s37, v51
    v_dot2c_f32_bf16 v8, v48, v48
    v_dot2c_f32_bf16 v9, v49, v49
    v_dot2c_f32_bf16 v10, v50, v50
    v_dot2c_f32_bf16 v11, v51, v51
    s_waitcnt vmcnt(8)
    v_dot2c_f32_bf16 v4, s37, v52
    v_dot2c_f32_bf16 v5, s37, v53
    v_dot2c_f32_bf16 v6, s37, v54
    v_dot2c_f32_bf16 v7, s37, v55
    v_dot2c_f32_bf16 v8, v52, v52
    v_dot2c_f32_bf16 v9, v53, v53
    v_dot2c_f32_bf16 v10, v54, v54
    v_dot2c_f32_bf16 v11, v55, v55
    s_waitcnt vmcnt(7)
    v_dot2c_f32_bf16 v4, s37, v56
    v_dot2c_f32_bf16 v5, s37, v57
    v_dot2c_f32_bf16 v6, s37, v58
    v_dot2c_f32_bf16 v7, s37, v59
    v_dot2c_f32_bf16 v8, v56, v56
    v_dot2c_f32_bf16 v9, v57, v57
    v_dot2c_f32_bf16 v10, v58, v58
    v_dot2c_f32_bf16 v11, v59, v59
    s_waitcnt vmcnt(6)
    v_dot2c_f32_bf16 v4, s37, v60
    v_dot2c_f32_bf16 v5, s37, v61
    v_dot2c_f32_bf16 v6, s37, v62
    v_dot2c_f32_bf16 v7, s37, v63
    v_dot2c_f32_bf16 v8, v60, v60
    v_dot2c_f32_bf16 v9, v61, v61
    v_dot2c_f32_bf16 v10, v62, v62
    v_dot2c_f32_bf16 v11, v63, v63
    s_waitcnt vmcnt(5)
    v_dot2c_f32_bf16 v4, s37, v64
    v_dot2c_f32_bf16 v5, s37, v65
    v_dot2c_f32_bf16 v6, s37, v66
    v_dot2c_f32_bf16 v7, s37, v67
    v_dot2c_f32_bf16 v8, v64, v64
    v_dot2c_f32_bf16 v9, v65, v65
    v_dot2c_f32_bf16 v10, v66, v66
    v_dot2c_f32_bf16 v11, v67, v67
    s_waitcnt vmcnt(4)
    v_dot2c_f32_bf16 v4, s37, v68
    v_dot2c_f32_bf16 v5, s37, v69
    v_dot2c_f32_bf16 v6, s37, v70
    v_dot2c_f32_bf16 v7, s37, v71
    v_dot2c_f32_bf16 v8, v68, v68
    v_dot2c_f32_bf16 v9, v69, v69
    v_dot2c_f32_bf16 v10, v70, v70
    v_dot2c_f32_bf16 v11, v71, v71
    s_waitcnt vmcnt(3)
    v_dot2c_f32_bf16 v4, s37, v72
    v_dot2c_f32_bf16 v5, s37, v73
    v_dot2c_f32_bf16 v6, s37, v74
    v_dot2c_f32_bf16 v7, s37, v75
    v_dot2c_f32_bf16 v8, v72, v72
    v_dot2c_f32_bf16 v9, v73, v73
    v_dot2c_f32_bf16 v10, v74, v74
    v_dot2c_f32_bf16 v11, v75, v75
    s_waitcnt vmcnt(2)
    v_dot2c_f32_bf16 v4, s37, v76
    v_dot2c_f32_bf16 v5, s37, v77
    v_dot2c_f32_bf16 v6, s37, v78
    v_dot2c_f32_bf16 v7, s37, v79
    v_dot2c_f32_bf16 v8, v76, v76
    v_dot2c_f32_bf16 v9, v77, v77
    v_dot2c_f32_bf16 v10, v78, v78
    v_dot2c_f32_bf16 v11, v79, v79
    s_waitcnt vmcnt(1)
    v_dot2c_f32_bf16 v4, s37, v80
    v_dot2c_f32_bf16 v5, s37, v81
    v_dot2c_f32_bf16 v6, s37, v82
    v_dot2c_f32_bf16 v7, s37, v83
    v_dot2c_f32_bf16 v8, v80, v80
    v_dot2c_f32_bf16 v9, v81, v81
    v_dot2c_f32_bf16 v10, v82, v82
    v_dot2c_f32_bf16 v11, v83, v83
    s_waitcnt vmcnt(0)
    v_dot2c_f32_bf16 v4, s37, v84
    v_dot2c_f32_bf16 v5, s37, v85
    v_dot2c_f32_bf16 v6, s37, v86
    v_dot2c_f32_bf16 v7, s37, v87
    v_dot2c_f32_bf16 v8, v84, v84
    v_dot2c_f32_bf16 v9, v85, v85
    v_dot2c_f32_bf16 v10, v86, v86
    v_dot2c_f32_bf16 v11, v87, v87
    s_lshl_b32 s35, s33, 12
    s_lshl_b32 s44, s34, 4
    s_waitcnt lgkmcnt(0)
    s_add_u32 s58, s41, 0x9e3779b9
    v_add_f32 v4, v4, v5
    v_add_f32 v6, v6, v7
    v_cvt_f64_f32 v[12:13], v8
    v_add_f32 v4, v4, v6
    v_cvt_f64_f32 v[6:7], v9
    v_cvt_f64_f32 v[8:9], v10
    v_cvt_f64_f32 v[10:11], v11
    v_add_f64 v[6:7], v[6:7], v[12:13]
    v_add_f64 v[8:9], v[8:9], v[10:11]
    v_add_f64 v[6:7], v[6:7], v[8:9]
    s_nop 1
    v_mov_b32_dpp v8, v6 row_shr:1 row_mask:0xf bank_mask:0xf bound_ctrl:0
    v_mov_b32_dpp v9, v7 row_shr:1 row_mask:0xf bank_mask:0xf bound_ctrl:0
    v_add_f32_dpp v4, v4, v4 row_shr:1 row_mask:0xf bank_mask:0xf bound_ctrl:0
    v_add_f64 v[6:7], v[6:7], v[8:9]
    s_nop 1
    v_mov_b32_dpp v8, v6 row_shr:2 row_mask:0xf bank_mask:0xf bound_ctrl:0
    v_mov_b32_dpp v9, v7 row_shr:2 row_mask:0xf bank_mask:0xf bound_ctrl:0
    v_add_f32_dpp v4, v4, v4 row_shr:2 row_mask:0xf bank_mask:0xf bound_ctrl:0
    v_add_f64 v[6:7], v[6:7], v[8:9]
    s_nop 1
    v_mov_b32_dpp v8, v6 row_shr:4 row_mask:0xf bank_mask:0xf bound_ctrl:0
    v_mov_b32_dpp v9, v7 row_shr:4 row_mask:0xf bank_mask:0xf bound_ctrl:0
    v_add_f32_dpp v4, v4, v4 row_shr:4 row_mask:0xf bank_mask:0xf bound_ctrl:0
    v_add_f64 v[6:7], v[6:7], v[8:9]
    s_nop 1
    v_mov_b32_dpp v8, v6 row_shr:8 row_mask:0xf bank_mask:0xf bound_ctrl:0
    v_mov_b32_dpp v9, v7 row_shr:8 row_mask:0xf bank_mask:0xf bound_ctrl:0
    v_add_f32_dpp v4, v4, v4 row_shr:8 row_mask:0xf bank_mask:0xf bound_ctrl:0
    v_add_f64 v[6:7], v[6:7], v[8:9]
    s_nop 1
    v_mov_b32_dpp v8, v6 row_bcast:15 row_mask:0xa bank_mask:0xf
    v_mov_b32_dpp v9, v7 row_bcast:15 row_mask:0xa bank_mask:0xf
    v_add_f32_dpp v4, v4, v4 row_bcast:15 row_mask:0xa bank_mask:0xf
    v_add_f64 v[6:7], v[6:7], v[8:9]
    s_nop 1
    v_mov_b32_dpp v8, v6 row_bcast:31 row_mask:0xc bank_mask:0xf
    v_mov_b32_dpp v9, v7 row_bcast:31 row_mask:0xc bank_mask:0xf
    v_add_f32_dpp v4, v4, v4 row_bcast:31 row_mask:0xc bank_mask:0xf
    v_add_f64 v[6:7], v[6:7], v[8:9]
    v_mul_f32 v4, 0x39000000, v4
    v_cvt_f64_f32 v[10:11], v4
    v_ldexp_f64 v[6:7], v[6:7], -13
    v_fma_f64 v[6:7], -v[10:11], v[10:11], v[6:7]
    v_cvt_f32_f64 v6, v[6:7]
    s_cmp_eq_u32 s43, 0
    v_readlane_b32 s60, v4, 63
    v_readlane_b32 s61, v6, 63
    s_cbranch_scc1 L_pub16
    s_lshr_b32 s35, s35, 1
    s_add_u32 s35, s35, 65536
    s_lshr_b32 s44, s44, 1
    s_add_u32 s44, s44, s35
    s_bitset0_b32 s61, 31
    s_atomic_swap_x2 s[60:61], s[14:15], s44
L_pub1:
    s_barrier
    s_and_b32 s44, s33, 31
    s_lshl_b32 s44, s44, 5
    s_add_u32 s44, s44, s42
    s_lshl_b32 s44, s44, 1
    s_and_b32 s44, s44, 0x7fc
    s_load_dword s52, s[6:7], s44
    s_load_dword s53, s[8:9], s44
    s_mov_b32 s57, 5
    s_barrier
    s_barrier
    s_barrier
    s_setprio 3
    s_barrier
    buffer_load_dwordx4 v[4:7], v20, s[24:27], s35 offen offset:0 sc1
    buffer_load_dwordx4 v[8:11], v20, s[24:27], s35 offen offset:1024 sc1
    s_cmp_lg_u32 s43, 0
    s_cbranch_scc1 L_p2
    buffer_load_dwordx4 v[12:15], v20, s[24:27], s35 offen offset:2048 sc1
    buffer_load_dwordx4 v[16:19], v20, s[24:27], s35 offen offset:3072 sc1
L_p2:
    s_mov_b32 s46, 300000
    s_barrier
L_poll:
    s_waitcnt vmcnt(0) lgkmcnt(0)
    s_cmp_eq_u32 s43, 0
    s_cbranch_scc1 L_chk16
    v_or_b32 v21, v5, v7
    v_or_b32 v2, v9, v11
    v_cmp_gt_i32 s[64:65], 0, v21
    v_cmp_gt_i32 s[66:67], 0, v2
    s_or_b64 vcc, s[64:65], s[66:67]
    s_cbranch_scc1 L_again
L_chk1:
    v_readfirstlane_b32 s44, v4
    s_bitcmp1_b32 s42, 0
    s_cselect_b32 s45, 0, 16
    v_subrev_f32 v4, s44, v4
    v_subrev_f32 v6, s44, v6
    v_subrev_f32 v8, s44, v8
    v_subrev_f32 v10, s44, v10
    v_fmac_f32 v5, v4, v4
    v_fmac_f32 v7, v6, v6
    v_fmac_f32 v9, v8, v8
    v_fmac_f32 v11, v10, v10
    v_add_f32 v4, v4, v6
    v_add_f32 v8, v8, v10
    v_add_f32 v5, v5, v7
    v_add_f32 v9, v9, v11
    v_add_f32 v4, v4, v8
    v_add_f32 v5, v5, v9
    s_nop 0
    v_add_f32_dpp v4, v4, v4 row_shr:1 row_mask:0xf bank_mask:0xf bound_ctrl:0
    v_add_f32_dpp v5, v5, v5 row_shr:1 row_mask:0xf bank_mask:0xf bound_ctrl:0
    s_nop 0
    v_add_f32_dpp v4, v4, v4 row_shr:2 row_mask:0xf bank_mask:0xf bound_ctrl:0
    v_add_f32_dpp v5, v5, v5 row_shr:2 row_mask:0xf bank_mask:0xf bound_ctrl:0
    s_nop 0
    v_add_f32_dpp v4, v4, v4 row_shr:4 row_mask:0xf bank_mask:0xf bound_ctrl:0
    v_add_f32_dpp v5, v5, v5 row_shr:4 row_mask:0xf bank_mask:0xf bound_ctrl:0
    s_nop 0
    v_add_f32_dpp v4, v4, v4 row_shr:8 row_mask:0xf bank_mask:0xf bound_ctrl:0
    v_add_f32_dpp v5, v5, v5 row_shr:8 row_mask:0xf bank_mask:0xf bound_ctrl:0
    s_nop 0
    v_add_f32_dpp v4, v4, v4 row_bcast:15 row_mask:0xa bank_mask:0xf
    v_add_f32_dpp v5, v5, v5 row_bcast:15 row_mask:0xa bank_mask:0xf
    s_nop 0
    v_add_f32_dpp v4, v4, v4 row_bcast:31 row_mask:0xc bank_mask:0xf
    v_add_f32_dpp v5, v5, v5 row_bcast:31 row_mask:0xc bank_mask:0xf
    s_lshl_b32 s52, s52, s45
    s_lshl_b32 s53, s53, s45
    v_readlane_b32 s46, v4, 63
    v_readlane_b32 s47, v5, 63
    s_and_b32 s52, s52, s38
    s_and_b32 s53, s53, s38
    v_mov_b32 v6, 0x3b800000
    v_mul_f32 v4, s46, v6
    v_mul_f32 v5, s47, v6
    v_fma_f32 v5, -v4, v4, v5
    v_add_f32 v6, s44, v4
    v_cvt_pk_bf16_f32 v12, v6, v6
    v_lshlrev_b32 v12, 16, v12
    v_sub_f32 v6, s44, v12
    v_add_f32 v6, v6, v4
    v_fmac_f32 v5, v6, v6
    v_cvt_pk_bf16_f32 v5, v5, v5
    v_lshlrev_b32 v5, 16, v5
    v_add_f32 v5, 0x3727c5ac, v5
    v_cvt_pk_bf16_f32 v5, v5, v5
    v_lshlrev_b32 v5, 16, v5
    v_sqrt_f32 v5, v5
    s_nop 0
    v_cvt_pk_bf16_f32 v5, v5, v5
    v_lshlrev_b32 v5, 16, v5
    v_rcp_f32 v5, v5
    s_nop 0
    v_mul_f32 v4, s52, v5
    v_cvt_pk_bf16_f32 v5, v4, v4
    v_and_b32 v13, s38, v5
    v_sub_f32 v4, v4, v13
    v_cvt_pk_bf16_f32 v7, v4, v4
    v_and_b32 v14, s38, v7
    v_add_f32 v13, v13, v14
    v_fma_f32 v8, -v12, v13, s53
    v_and_b32 v4, v5, v22
    v_and_b32 v5, v5, v23
    v_and_b32 v6, v7, v22
    v_and_b32 v7, v7, v23
    v_mov_b32 v9, v8
    v_mov_b32 v10, v8
    v_mov_b32 v11, v8
    s_nop 1
    v_mfma_f32_4x4x4_16b_bf16 v[88:91], v[4:5], v[24:25], v[8:11]
    v_mfma_f32_4x4x4_16b_bf16 v[92:95], v[4:5], v[26:27], v[8:11]
    v_mfma_f32_4x4x4_16b_bf16 v[96:99], v[4:5], v[28:29], v[8:11]
    v_mfma_f32_4x4x4_16b_bf16 v[100:103], v[4:5], v[30:31], v[8:11]
    v_mfma_f32_4x4x4_16b_bf16 v[88:91], v[6:7], v[24:25], v[88:91]
    v_mfma_f32_4x4x4_16b_bf16 v[92:95], v[6:7], v[26:27], v[92:95]
    v_mfma_f32_4x4x4_16b_bf16 v[96:99], v[6:7], v[28:29], v[96:99]
    v_mfma_f32_4x4x4_16b_bf16 v[100:103], v[6:7], v[30:31], v[100:103]
    s_nop 1
    v_mfma_f32_4x4x4_16b_bf16 v[104:107], v[4:5], v[32:33], v[8:11]
    v_cvt_pk_bf16_f32 v24, v88, v89
    v_mfma_f32_4x4x4_16b_bf16 v[108:111], v[4:5], v[34:35], v[8:11]
    v_cvt_pk_bf16_f32 v25, v90, v91
    v_mfma_f32_4x4x4_16b_bf16 v[112:115], v[4:5], v[36:37], v[8:11]
    v_cvt_pk_bf16_f32 v26, v92, v93
    v_mfma_f32_4x4x4_16b_bf16 v[116:119], v[4:5], v[38:39], v[8:11]
    v_cvt_pk_bf16_f32 v27, v94, v95
    v_mfma_f32_4x4x4_16b_bf16 v[104:107], v[6:7], v[32:33], v[104:107]
    v_cvt_pk_bf16_f32 v28, v96, v97
    v_mfma_f32_4x4x4_16b_bf16 v[108:111], v[6:7], v[34:35], v[108:111]
    v_cvt_pk_bf16_f32 v29, v98, v99
    v_mfma_f32_4x4x4_16b_bf16 v[112:115], v[6:7], v[36:37], v[112:115]
    v_cvt_pk_bf16_f32 v30, v100, v101
    v_mfma_f32_4x4x4_16b_bf16 v[116:119], v[6:7], v[38:39], v[116:119]
    v_cvt_pk_bf16_f32 v31, v102, v103
    v_mfma_f32_4x4x4_16b_bf16 v[88:91], v[4:5], v[40:41], v[8:11]
    v_cvt_pk_bf16_f32 v32, v104, v105
    v_mfma_f32_4x4x4_16b_bf16 v[92:95], v[4:5], v[42:43], v[8:11]
    v_cvt_pk_bf16_f32 v33, v106, v107
    v_mfma_f32_4x4x4_16b_bf16 v[96:99], v[4:5], v[44:45], v[8:11]
    v_cvt_pk_bf16_f32 v34, v108, v109
    v_mfma_f32_4x4x4_16b_bf16 v[100:103], v[4:5], v[46:47], v[8:11]
    v_cvt_pk_bf16_f32 v35, v110, v111
    v_mfma_f32_4x4x4_16b_bf16 v[88:91], v[6:7], v[40:41], v[88:91]
    v_cvt_pk_bf16_f32 v36, v112, v113
    v_mfma_f32_4x4x4_16b_bf16 v[92:95], v[6:7], v[42:43], v[92:95]
    v_cvt_pk_bf16_f32 v37, v114, v115
    v_mfma_f32_4x4x4_16b_bf16 v[96:99], v[6:7], v[44:45], v[96:99]
    v_cvt_pk_bf16_f32 v38, v116, v117
    v_mfma_f32_4x4x4_16b_bf16 v[100:103], v[6:7], v[46:47], v[100:103]
    v_cvt_pk_bf16_f32 v39, v118, v119
    v_mfma_f32_4x4x4_16b_bf16 v[104:107], v[4:5], v[48:49], v[8:11]
    v_cvt_pk_bf16_f32 v40, v88, v89
    v_mfma_f32_4x4x4_16b_bf16 v[108:111], v[4:5], v[50:51], v[8:11]
    v_cvt_pk_bf16_f32 v41, v90, v91
    v_mfma_f32_4x4x4_16b_bf16 v[112:115], v[4:5], v[52:53], v[8:11]
    v_cvt_pk_bf16_f32 v42, v92, v93
    v_mfma_f32_4x4x4_16b_bf16 v[116:119], v[4:5], v[54:55], v[8:11]
    v_cvt_pk_bf16_f32 v43, v94, v95
    v_mfma_f32_4x4x4_16b_bf16 v[104:107], v[6:7], v[48:49], v[104:107]
    v_cvt_pk_bf16_f32 v44, v96, v97
    v_mfma_f32_4x4x4_16b_bf16 v[108:111], v[6:7], v[50:51], v[108:111]
    v_cvt_pk_bf16_f32 v45, v98, v99
    v_mfma_f32_4x4x4_16b_bf16 v[112:115], v[6:7], v[52:53], v[112:115]
    v_cvt_pk_bf16_f32 v46, v100, v101
    v_mfma_f32_4x4x4_16b_bf16 v[116:119], v[6:7], v[54:55], v[116:119]
    v_cvt_pk_bf16_f32 v47, v102, v103
    v_mfma_f32_4x4x4_16b_bf16 v[88:91], v[4:5], v[56:57], v[8:11]
    v_cvt_pk_bf16_f32 v48, v104, v105
    v_mfma_f32_4x4x4_16b_bf16 v[92:95], v[4:5], v[58:59], v[8:11]
    v_cvt_pk_bf16_f32 v49, v106, v107
    v_mfma_f32_4x4x4_16b_bf16 v[96:99], v[4:5], v[60:61], v[8:11]
    v_cvt_pk_bf16_f32 v50, v108, v109
    v_mfma_f32_4x4x4_16b_bf16 v[100:103], v[4:5], v[62:63], v[8:11]
    v_cvt_pk_bf16_f32 v51, v110, v111
    v_mfma_f32_4x4x4_16b_bf16 v[88:91], v[6:7], v[56:57], v[88:91]
    v_cvt_pk_bf16_f32 v52, v112, v113
    v_mfma_f32_4x4x4_16b_bf16 v[92:95], v[6:7], v[58:59], v[92:95]
    v_cvt_pk_bf16_f32 v53, v114, v115
    v_mfma_f32_4x4x4_16b_bf16 v[96:99], v[6:7], v[60:61], v[96:99]
    v_cvt_pk_bf16_f32 v54, v116, v117
    v_mfma_f32_4x4x4_16b_bf16 v[100:103], v[6:7], v[62:63], v[100:103]
    v_cvt_pk_bf16_f32 v55, v118, v119
    v_mfma_f32_4x4x4_16b_bf16 v[104:107], v[4:5], v[64:65], v[8:11]
    v_cvt_pk_bf16_f32 v56, v88, v89
    v_mfma_f32_4x4x4_16b_bf16 v[108:111], v[4:5], v[66:67], v[8:11]
    v_cvt_pk_bf16_f32 v57, v90, v91
    v_mfma_f32_4x4x4_16b_bf16 v[112:115], v[4:5], v[68:69], v[8:11]
    v_cvt_pk_bf16_f32 v58, v92, v93
    v_mfma_f32_4x4x4_16b_bf16 v[116:119], v[4:5], v[70:71], v[8:11]
    v_cvt_pk_bf16_f32 v59, v94, v95
    v_mfma_f32_4x4x4_16b_bf16 v[104:107], v[6:7], v[64:65], v[104:107]
    v_cvt_pk_bf16_f32 v60, v96, v97
    v_mfma_f32_4x4x4_16b_bf16 v[108:111], v[6:7], v[66:67], v[108:111]
    v_cvt_pk_bf16_f32 v61, v98, v99
    v_mfma_f32_4x4x4_16b_bf16 v[112:115], v[6:7], v[68:69], v[112:115]
    v_cvt_pk_bf16_f32 v62, v100, v101
    v_mfma_f32_4x4x4_16b_bf16 v[116:119], v[6:7], v[70:71], v[116:119]
    v_cvt_pk_bf16_f32 v63, v102, v103
    v_mfma_f32_4x4x4_16b_bf16 v[88:91], v[4:5], v[72:73], v[8:11]
    v_cvt_pk_bf16_f32 v64, v104, v105
    v_mfma_f32_4x4x4_16b_bf16 v[92:95], v[4:5], v[74:75], v[8:11]
    v_cvt_pk_bf16_f32 v65, v106, v107
    v_mfma_f32_4x4x4_16b_bf16 v[96:99], v[4:5], v[76:77], v[8:11]
    v_cvt_pk_bf16_f32 v66, v108, v109
    v_mfma_f32_4x4x4_16b_bf16 v[100:103], v[4:5], v[78:79], v[8:11]
    v_cvt_pk_bf16_f32 v67, v110, v111
    v_mfma_f32_4x4x4_16b_bf16 v[88:91], v[6:7], v[72:73], v[88:91]
    v_cvt_pk_bf16_f32 v68, v112, v113
    v_mfma_f32_4x4x4_16b_bf16 v[92:95], v[6:7], v[74:75], v[92:95]
    v_cvt_pk_bf16_f32 v69, v114, v115
    v_mfma_f32_4x4x4_16b_bf16 v[96:99], v[6:7], v[76:77], v[96:99]
    v_cvt_pk_bf16_f32 v70, v116, v117
    v_mfma_f32_4x4x4_16b_bf16 v[100:103], v[6:7], v[78:79], v[100:103]
    v_cvt_pk_bf16_f32 v71, v118, v119
    v_mfma_f32_4x4x4_16b_bf16 v[104:107], v[4:5], v[80:81], v[8:11]
    v_cvt_pk_bf16_f32 v72, v88, v89
    v_mfma_f32_4x4x4_16b_bf16 v[108:111], v[4:5], v[82:83], v[8:11]
    v_cvt_pk_bf16_f32 v73, v90, v91
    v_mfma_f32_4x4x4_16b_bf16 v[112:115], v[4:5], v[84:85], v[8:11]
    v_cvt_pk_bf16_f32 v74, v92, v93
    v_mfma_f32_4x4x4_16b_bf16 v[116:119], v[4:5], v[86:87], v[8:11]
    v_cvt_pk_bf16_f32 v75, v94, v95
    v_mfma_f32_4x4x4_16b_bf16 v[104:107], v[6:7], v[80:81], v[104:107]
    v_cvt_pk_bf16_f32 v76, v96, v97
    v_mfma_f32_4x4x4_16b_bf16 v[108:111], v[6:7], v[82:83], v[108:111]
    v_cvt_pk_bf16_f32 v77, v98, v99
    v_mfma_f32_4x4x4_16b_bf16 v[112:115], v[6:7], v[84:85], v[112:115]
    v_cvt_pk_bf16_f32 v78, v100, v101
    v_mfma_f32_4x4x4_16b_bf16 v[116:119], v[6:7], v[86:87], v[116:119]
    v_cvt_pk_bf16_f32 v79, v102, v103
    v_cvt_pk_bf16_f32 v80, v104, v105
    v_cvt_pk_bf16_f32 v81, v106, v107
    v_cvt_pk_bf16_f32 v82, v108, v109
    v_cvt_pk_bf16_f32 v83, v110, v111
    v_cvt_pk_bf16_f32 v84, v112, v113
    v_cvt_pk_bf16_f32 v85, v114, v115
    v_cvt_pk_bf16_f32 v86, v116, v117
    v_cvt_pk_bf16_f32 v87, v118, v119
    s_barrier
    s_setprio 0
    buffer_store_dwordx4 v[24:27], v20, s[20:23], s28 offen offset:0 sc1
    buffer_store_dwordx4 v[28:31], v20, s[20:23], s28 offen offset:1024 sc1
    buffer_store_dwordx4 v[32:35], v20, s[20:23], s28 offen offset:2048 sc1
    buffer_store_dwordx4 v[36:39], v20, s[20:23], s28 offen offset:3072 sc1
    buffer_store_dwordx4 v[40:43], v20, s[20:23], s29 offen offset:0 sc1
    buffer_store_dwordx4 v[44:47], v20, s[20:23], s29 offen offset:1024 sc1
    buffer_store_dwordx4 v[48:51], v20, s[20:23], s29 offen offset:2048 sc1
    buffer_store_dwordx4 v[52:55], v20, s[20:23], s29 offen offset:3072 sc1
    buffer_store_dwordx4 v[56:59], v20, s[20:23], s30 offen offset:0 sc1
    buffer_store_dwordx4 v[60:63], v20, s[20:23], s30 offen offset:1024 sc1
    buffer_store_dwordx4 v[64:67], v20, s[20:23], s30 offen offset:2048 sc1
    buffer_store_dwordx4 v[68:71], v20, s[20:23], s30 offen offset:3072 sc1
    buffer_store_dwordx4 v[72:75], v20, s[20:23], s31 offen offset:0 sc1
    buffer_store_dwordx4 v[76:79], v20, s[20:23], s31 offen offset:1024 sc1
    buffer_store_dwordx4 v[80:83], v20, s[20:23], s31 offen offset:2048 sc1
    buffer_store_dwordx4 v[84:87], v20, s[20:23], s31 offen offset:3072 sc1
    s_lshl_b32 s44, s33, 8
    s_or_b32 s44, s44, s34
    s_cmp_eq_u32 s44, 768
    s_cbranch_scc1 L_epo
L_epo1:
    s_barrier
    s_cmp_ge_u32 s33, 58
    s_cbranch_scc1 L_fin3
L_idle:
    s_min_u32 s45, s57, s39
    s_sub_u32 s39, s39, s45
    s_sub_u32 s57, s57, s45
L_idle1:
    s_cmp_eq_u32 s57, 0
    s_cbranch_scc1 L_next
    s_barrier
    s_sub_u32 s57, s57, 1
    s_branch L_idle1
L_next:
    s_cmp_eq_u32 s43, 0
    s_cbranch_scc1 L_role0
    s_mov_b32 s56, -1
    s_cmp_ge_u32 s33, 50
    s_cbranch_scc1 L_drawn
L_draw:
    s_mov_b32 s56, 1
    s_atomic_add s56, s[14:15], s54 glc
L_drawn:
    s_barrier
    s_waitcnt lgkmcnt(0)
    s_cmp_ge_u32 s56, 448
    s_cbranch_scc1 L_fin
    s_lshr_b32 s33, s56, 3
    s_add_u32 s33, s33, 8
    s_and_b32 s44, s56, 7
    s_lshl_b32 s44, s44, 4
    s_or_b32 s44, s44, s3
    s_mul_i32 s45, s3, 4352
    s_sub_u32 s54, s54, s45
    s_add_u32 s3, s3, s56
    s_and_b32 s3, s3, 15
    s_mul_i32 s45, s3, 4352
    s_add_u32 s54, s54, s45
    s_lshr_b32 s42, s44, 2
    s_lshl_b32 s34, s44, 1
    s_and_b32 s45, s43, 1
    s_or_b32 s34, s34, s45
    s_lshl_b32 s44, s44, 15
    s_lshl_b32 s45, s33, 22
    s_or_b32 s28, s44, s45
    s_or_b32 s29, s28, 0x1000
    s_lshl_b32 s46, s43, 13
    s_add_u32 s44, s28, s4
    s_lshr_b32 s45, s44, 8
    s_xor_b32 s44, s44, s45
    s_xor_b32 s44, s44, s46
    s_and_b32 s44, s44, 0x2000
    s_or_b32 s28, s28, s44
    s_or_b32 s30, s28, 0x4000
    s_add_u32 s44, s29, s4
    s_lshr_b32 s45, s44, 8
    s_xor_b32 s44, s44, s45
    s_xor_b32 s44, s44, s46
    s_and_b32 s44, s44, 0x2000
    s_or_b32 s29, s29, s44
    s_or_b32 s31, s29, 0x4000
L_prebar:
    s_branch L_t0
L_again:
    s_mov_b64 exec, s[64:65]
    s_cbranch_execz L_skip0
    buffer_load_dwordx4 v[4:7], v20, s[24:27], s35 offen offset:0 sc1
L_skip0:
    s_mov_b64 exec, s[66:67]
    s_cbranch_execz L_skip1
    buffer_load_dwordx4 v[8:11], v20, s[24:27], s35 offen offset:1024 sc1
L_skip1:
    s_mov_b64 exec, s[68:69]
    s_cbranch_execz L_skip2
    buffer_load_dwordx4 v[12:15], v20, s[24:27], s35 offen offset:2048 sc1
L_skip2:
    s_mov_b64 exec, s[70:71]
    s_cbranch_execz L_skip3
    buffer_load_dwordx4 v[16:19], v20, s[24:27], s35 offen offset:3072 sc1
L_skip3:
    s_mov_b64 exec, -1
    s_barrier
    s_add_u32 s39, s39, 1
    s_sub_u32 s46, s46, 1
    s_cmp_lg_u32 s46, 0
    s_cbranch_scc1 L_poll
    s_branch L_end
L_pub16:
    s_add_u32 s44, s44, s35
    s_mov_b32 s62, s61
    s_mov_b32 s61, s58
    s_mov_b32 s63, s58
    s_add_u32 s45, s44, 8
    s_atomic_swap_x2 s[60:61], s[14:15], s44
    s_atomic_swap_x2 s[62:63], s[14:15], s45
    s_branch L_pub1
L_chk16:
    v_xor_b32 v21, s58, v5
    v_xor_b32 v2, s58, v7
    v_or_b32 v21, v21, v2
    v_cmp_ne_u32 s[64:65], 0, v21
    v_xor_b32 v21, s58, v9
    v_xor_b32 v2, s58, v11
    v_or_b32 v21, v21, v2
    v_cmp_ne_u32 s[66:67], 0, v21
    v_xor_b32 v21, s58, v13
    v_xor_b32 v2, s58, v15
    v_or_b32 v21, v21, v2
    v_cmp_ne_u32 s[68:69], 0, v21
    v_xor_b32 v21, s58, v17
    v_xor_b32 v2, s58, v19
    v_or_b32 v21, v21, v2
    v_cmp_ne_u32 s[70:71], 0, v21
    s_or_b64 s[44:45], s[64:65], s[66:67]
    s_or_b64 vcc, s[68:69], s[70:71]
    s_or_b64 vcc, vcc, s[44:45]
    s_cbranch_scc1 L_again
    v_mov_b32 v5, v6
    v_mov_b32 v6, v8
    v_mov_b32 v7, v10
    v_mov_b32 v8, v12
    v_mov_b32 v9, v14
    v_mov_b32 v10, v16
    v_mov_b32 v11, v18
    s_branch L_chk1
L_epo:
    v_mov_b32 v4, s58
    v_mov_b32 v5, 264192
    s_mov_b64 exec, 1
    buffer_store_dword v4, v5, s[24:27], 0 offen sc1
    s_mov_b64 exec, -1
    s_branch L_epo1
L_role0:
    s_mov_b32 s46, 300000
L_role:
    v_mov_b32 v4, 0
    ds_read_b32 v4, v4
    s_waitcnt lgkmcnt(0)
    v_readfirstlane_b32 s43, v4
    s_cmp_lg_u32 s43, 0
    s_cbranch_scc1 L_role1
    s_barrier
    s_add_u32 s39, s39, 1
    s_sub_u32 s46, s46, 1
    s_cmp_lg_u32 s46, 0
    s_cbranch_scc1 L_role
    s_branch L_end
L_role1:
    s_mov_b64 s[68:69], 0
    s_mov_b64 s[70:71], 0
    s_lshr_b32 s3, s2, 3
    s_add_u32 s3, s3, s36
    s_and_b32 s3, s3, 15
    s_and_b32 s44, s43, 1
    s_mul_i32 s44, s44, 16
    s_add_u32 s44, s44, s3
    s_mul_i32 s44, s44, 4352
    s_add_u32 s54, s44, 266240
    s_branch L_draw
L_fin:
    s_cmp_ge_u32 s33, 58
    s_cbranch_scc1 L_fin2
    v_lshlrev_b32 v4, 3, v20
    s_mov_b32 exec_hi, 0
    buffer_load_dword v24, v4, s[16:19], s28 offen nt
L_fin2:
    s_barrier
    s_barrier
L_fin3:
    s_barrier
L_end:
    s_endpgm
.p2align 6
L_w15:
    s_waitcnt lgkmcnt(0)
    s_memtime s[48:49]
    s_waitcnt lgkmcnt(0)
    s_load_dword s47, s[12:13], 0 glc
    s_waitcnt lgkmcnt(0)
    s_memtime s[50:51]
    s_barrier
    s_getreg_b32 s40, hwreg(HW_REG_XCC_ID)
    s_bfe_u32 s40, s40, 0x10002
    v_mov_b32 v4, 0
    ds_write_b32 v4, v4
    s_waitcnt lgkmcnt(0)
    s_sub_u32 s46, s50, s48
    s_sub_i32 s46, s46, 300
    s_ashr_i32 s46, s46, 5
    s_min_i32 s46, s46, 63
    s_max_i32 s46, s46, 0
    s_bfe_u32 s47, s2, 0x10003
    s_cmp_eq_u32 s47, s40
    s_cselect_b32 s47, 0, 63
    s_xor_b32 s46, s46, s47
    s_lshl_b32 s47, s40, 6
    s_or_b32 s46, s46, s47
    s_add_u32 s58, s41, 0x9e3779b9
    s_and_b32 s47, s58, 0xffffff00
    s_or_b32 s59, s46, s47
    s_lshl_b32 s46, s2, 3
    s_add_u32 s46, s46, 262144
    s_waitcnt vmcnt(0)
    s_mov_b64 s[62:63], s[58:59]
    s_atomic_swap_x2 s[62:63], s[14:15], s46
    s_mov_b32 s45, 262144
    s_mov_b32 s46, 300000
    s_setprio 3
    s_barrier
    s_barrier
    s_barrier
L_ann:
    buffer_load_dwordx4 v[4:7], v20, s[24:27], s45 offen sc1
    buffer_load_dwordx4 v[8:11], v20, s[24:27], s45 offen offset:1024 sc1
    s_barrier
    s_waitcnt vmcnt(0)
    v_xor_b32 v4, s58, v4
    v_xor_b32 v6, s58, v6
    v_xor_b32 v8, s58, v8
    v_xor_b32 v10, s58, v10
    v_xor_b32 v12, s58, v5
    v_xor_b32 v13, s58, v7
    v_xor_b32 v14, s58, v9
    v_xor_b32 v15, s58, v11
    v_or3_b32 v12, v12, v13, v14
    v_or_b32 v12, v12, v15
    v_and_b32 v12, 0xffffff00, v12
    v_or3_b32 v12, v12, v4, v6
    v_or3_b32 v12, v12, v8, v10
    v_cmp_ne_u32 vcc, 0, v12
    s_cbranch_vccz L_annok
    s_add_u32 s39, s39, 1
    s_sub_u32 s46, s46, 1
    s_cmp_lg_u32 s46, 0
    s_cbranch_scc1 L_ann
    s_branch L_end
L_annok:
    v_and_b32 v4, 64, v5
    v_and_b32 v5, 63, v5
    v_and_b32 v6, 64, v7
    v_and_b32 v7, 63, v7
    v_and_b32 v8, 64, v9
    v_and_b32 v9, 63, v9
    v_and_b32 v10, 64, v11
    v_and_b32 v11, 63, v11
    v_add3_u32 v4, v4, v6, v8
    v_add3_u32 v5, v5, v7, v9
    v_add_u32 v4, v4, v10
    v_add_u32 v5, v5, v11
    v_lshl_add_u32 v5, v4, 10, v5
    s_nop 1
    v_add_u32_dpp v5, v5, v5 row_shr:1 row_mask:0xf bank_mask:0xf bound_ctrl:0
    s_nop 1
    v_add_u32_dpp v5, v5, v5 row_shr:2 row_mask:0xf bank_mask:0xf bound_ctrl:0
    s_nop 1
    v_add_u32_dpp v5, v5, v5 row_shr:4 row_mask:0xf bank_mask:0xf bound_ctrl:0
    s_nop 1
    v_add_u32_dpp v5, v5, v5 row_shr:8 row_mask:0xf bank_mask:0xf bound_ctrl:0
    s_nop 1
    v_add_u32_dpp v5, v5, v5 row_bcast:15 row_mask:0xa bank_mask:0xf
    s_nop 1
    v_add_u32_dpp v5, v5, v5 row_bcast:31 row_mask:0xc bank_mask:0xf
    s_bfe_u32 s46, s2, 0x10002
    v_readlane_b32 s44, v5, 63
    s_lshr_b32 s45, s44, 16
    s_and_b32 s44, s44, 0xffff
    s_cmp_eq_u32 s45, 128
    s_cselect_b32 s46, s40, s46
    s_cmp_gt_u32 s44, 8064
    s_cselect_b32 s44, 1, 0
    s_xor_b32 s44, s44, s46
    s_or_b32 s44, s44, 2
    v_mov_b32 v4, 0
    v_mov_b32 v5, s44
    ds_write_b32 v4, v5
    s_waitcnt lgkmcnt(0)
    s_setprio 0
    s_mov_b32 s57, 8
    s_branch L_idle
L_last:
    s_endpgm
.section .rodata,"a"
.p2align 6
.amdhsa_kernel standalone__groupnorm__prompt_kernel
  .amdhsa_next_free_vgpr 120
  .amdhsa_next_free_sgpr 72
  .amdhsa_accum_offset 120
  .amdhsa_group_segment_fixed_size 0
  .amdhsa_kernarg_size 48
  .amdhsa_user_sgpr_count 2
  .amdhsa_user_sgpr_kernarg_segment_ptr 1
  .amdhsa_system_sgpr_workgroup_id_x 1
  .amdhsa_float_denorm_mode_32 3
.end_amdhsa_kernel
```
